```python
import torch

def _softmax(x, axis=-1):
    return torch.softmax(x, dim=axis)
def _gelu(x):
    return torch.nn.functional.gelu(x, approximate="tanh")
def _silu(x):
    return torch.nn.functional.silu(x)
def _sigmoid(x):
    return torch.sigmoid(x)
def _layernorm(x, axis=-1, eps=1e-5):
    m = x.mean(dim=axis, keepdim=True)
    v = x.var(dim=axis, keepdim=True, unbiased=False)
    return (x - m) / torch.sqrt(v + eps)
def _scatter_add(tgt, idx, src, axis=0):
    return tgt.clone().index_add_(axis, idx, src)
def _segment_sum(src, seg, n):
    out = torch.zeros((n,) + src.shape[1:], dtype=src.dtype)
    return out.index_add_(0, seg, src)
def _pad(x, pw):
    flat = tuple(v for pair in reversed(pw) for v in pair)
    return torch.nn.functional.pad(x, flat)

kernel_name = 'standalone__paged_block_table_kv_pagedattention__sampling'

def setup_inputs():

    _w = (lambda a: (lambda t: t.to(torch.bfloat16) if t.is_floating_point() else t)(torch.as_tensor(a)))
    B, Hq, Hkv, Sq, Skv, D = 16, 32, 4, 8, 4096, 128
    bs = 16
    nbps = max(1, Skv // bs)
    num_phys = B * nbps + 4
    bt = torch.randperm(num_phys)[: B * nbps].reshape(B, nbps).to(torch.int64)
    cl = (nbps * bs - (torch.arange(1, B + 1, dtype=torch.int64) * 2654435761) % max(1, nbps * bs // 2)).to(torch.int64)
    return {
        "q": _w((lambda *s: torch.randn(*s, dtype=torch.bfloat16) * 0.8)(B, Hq, Sq, D)),
        "k_cache": _w((lambda *s: torch.randn(*s, dtype=torch.bfloat16) * 0.8)(num_phys, bs, Hkv, D)),
        "v_cache": _w((lambda *s: torch.randn(*s, dtype=torch.bfloat16) * 0.05)(num_phys, bs, Hkv, D)),
        "block_table": _w(bt),
        "context_lens": _w(cl),
    }

def reference(q, k_cache, v_cache, block_table, context_lens):
    B, Hq, Sq, D = q.shape
    bs = k_cache.shape[1]
    Hkv = k_cache.shape[2]
    nbps = block_table.shape[1]
    Skv = nbps * bs
    bt = block_table.reshape(-1)
    k = (lambda x, *d: x.permute(*d))(k_cache[bt].reshape(B, Skv, Hkv, D), 0, 2, 1, 3)
    v = (lambda x, *d: x.permute(*d))(v_cache[bt].reshape(B, Skv, Hkv, D), 0, 2, 1, 3)
    g = Hq // Hkv
    qg = q.reshape(B, Hkv, g, Sq, D)
    scores = torch.einsum("bhgqd,bhkd->bhgqk", qg, k) * (D ** -0.5)
    pos = torch.arange(Skv)
    msk = pos[None, :] < context_lens[:, None]
    scores = torch.where(msk[:, None, None, None, :], scores, -1e9)
    p = _softmax(scores, axis=-1)
    out = torch.einsum("bhgqk,bhkd->bhgqd", p, v)
    return out.reshape(B, Hq, Sq, D)
```

```asm
; @launch kernel=standalone__paged_block_table_kv_pagedattention__sampling_kernel grid=(256,1,1) block=(256,1,1) lds=49152
; @launch kernel=pa_combine_kernel grid=(512,1,1) block=(256,1,1) lds=0
.amdgcn_target "amdgcn-amd-amdhsa--gfx950"
.text
.globl standalone__paged_block_table_kv_pagedattention__sampling_kernel
.p2align 8
.type standalone__paged_block_table_kv_pagedattention__sampling_kernel,@function
standalone__paged_block_table_kv_pagedattention__sampling_kernel:
    s_load_dwordx16 s[4:19], s[0:1], 0
    s_lshr_b32 s40, s2, 6
    s_and_b32 s41, s2, 15
    s_bfe_u32 s42, s2, 0x20004
    v_lshrrev_b32 v2, 6, v0
    v_and_b32 v1, 63, v0
    v_readfirstlane_b32 s43, v2
    s_lshl_b32 s45, s40, 10
    s_lshl_b32 s3, s41, 2
    s_waitcnt lgkmcnt(0)
    s_load_dword s44, s[12:13], s3
    s_mov_b32 s20, s6
    s_mov_b32 s21, s7
    s_mov_b32 s22, 0x4010000
    s_mov_b32 s23, 0x20000
    s_mov_b32 s24, s8
    s_mov_b32 s25, s9
    s_mov_b32 s26, 0x4010000
    s_mov_b32 s27, 0x20000
    s_mov_b32 s28, s4
    s_mov_b32 s29, s5
    s_mov_b32 s30, 0x100000
    s_mov_b32 s31, 0x20000
    s_mov_b32 s32, s18
    s_mov_b32 s33, s19
    s_mov_b32 s34, 0x10040000
    s_mov_b32 s35, 0x20000
    s_mov_b32 s36, s10
    s_mov_b32 s37, s11
    s_mov_b32 s38, 0x4000
    s_mov_b32 s39, 0x20000
    s_lshl_b32 s3, s41, 8
    s_lshl_b32 s55, s40, 6
    s_add_u32 s3, s3, s55
    s_lshl_b32 s3, s3, 2
    v_lshlrev_b32 v2, 2, v1
    buffer_load_dword v148, v2, s[36:39], s3 offen
    v_and_b32 v3, 15, v1
    v_lshrrev_b32 v4, 4, v1
    v_lshlrev_b32 v2, 8, v3
    v_lshl_add_u32 v2, v4, 4, v2
    s_lshl_b32 s3, s41, 16
    s_lshl_b32 s55, s42, 14
    s_add_u32 s3, s3, s55
    s_lshl_b32 s55, s43, 12
    s_add_u32 s3, s3, s55
    buffer_load_dwordx4 v[8:11], v2, s[28:31], s3 offen offset:0
    buffer_load_dwordx4 v[12:15], v2, s[28:31], s3 offen offset:64
    buffer_load_dwordx4 v[16:19], v2, s[28:31], s3 offen offset:128
    buffer_load_dwordx4 v[20:23], v2, s[28:31], s3 offen offset:192
    v_xor_b32 v154, v4, v3
    v_xor_b32 v155, 0, v154
    v_lshlrev_b32 v155, 4, v155
    v_lshl_add_u32 v132, v3, 8, v155
    v_xor_b32 v155, 4, v154
    v_lshlrev_b32 v155, 4, v155
    v_lshl_add_u32 v133, v3, 8, v155
    v_xor_b32 v155, 8, v154
    v_lshlrev_b32 v155, 4, v155
    v_lshl_add_u32 v134, v3, 8, v155
    v_xor_b32 v155, 12, v154
    v_lshlrev_b32 v155, 4, v155
    v_lshl_add_u32 v135, v3, 8, v155
    v_lshrrev_b32 v154, 2, v3
    v_lshl_add_u32 v155, v4, 2, v154
    v_and_b32 v156, 1, v4
    v_lshl_add_u32 v156, v156, 2, v154
    v_lshlrev_b32 v156, 1, v156
    v_bfe_u32 v157, v3, 1, 1
    v_xor_b32 v157, v157, v156
    v_lshlrev_b32 v157, 4, v157
    v_lshl_add_u32 v157, v155, 8, v157
    v_and_b32 v158, 1, v3
    v_lshl_add_u32 v157, v158, 3, v157
    v_xor_b32 v136, 0, v157
    v_xor_b32 v137, 32, v157
    v_xor_b32 v138, 64, v157
    v_xor_b32 v139, 96, v157
    v_xor_b32 v140, 128, v157
    v_xor_b32 v141, 160, v157
    v_xor_b32 v142, 192, v157
    v_xor_b32 v143, 224, v157
    s_and_b32 s3, s43, 1
    s_lshl_b32 s3, s3, 1
    v_xor_b32 v154, v3, v4
    v_lshlrev_b32 v155, 1, v4
    v_xor_b32 v155, v3, v155
    s_add_u32 s55, s3, 0
    s_lshl_b32 s51, s55, 2
    v_xor_b32 v156, s51, v154
    v_lshlrev_b32 v156, 4, v156
    v_lshl_add_u32 v156, v4, 10, v156
    s_lshl_b32 s51, s55, 12
    v_add_u32 v144, s51, v156
    v_xor_b32 v157, 0, v155
    v_lshlrev_b32 v157, 4, v157
    v_lshl_add_u32 v157, v4, 10, v157
    v_add_u32 v146, s51, v157
    s_add_u32 s55, s3, 1
    s_lshl_b32 s51, s55, 2
    v_xor_b32 v156, s51, v154
    v_lshlrev_b32 v156, 4, v156
    v_lshl_add_u32 v156, v4, 10, v156
    s_lshl_b32 s51, s55, 12
    v_add_u32 v145, s51, v156
    v_xor_b32 v157, 8, v155
    v_lshlrev_b32 v157, 4, v157
    v_lshl_add_u32 v157, v4, 10, v157
    v_add_u32 v147, s51, v157
    v_lshlrev_b32 v166, 2, v4
    s_lshl_b32 s52, s43, 11
    s_lshl_b32 s50, s42, 8
    s_mov_b32 s51, 0x4010000
    s_mov_b32 s54, 0x3e0293ee
    s_lshr_b32 s48, s43, 1
    v_mov_b32 v24, 0
    v_mov_b32 v25, 0
    v_mov_b32 v26, 0
    v_mov_b32 v27, 0
    v_mov_b32 v28, 0
    v_mov_b32 v29, 0
    v_mov_b32 v30, 0
    v_mov_b32 v31, 0
    v_mov_b32 v32, 0
    v_mov_b32 v33, 0
    v_mov_b32 v34, 0
    v_mov_b32 v35, 0
    v_mov_b32 v36, 0
    v_mov_b32 v37, 0
    v_mov_b32 v38, 0
    v_mov_b32 v39, 0
    v_mov_b32 v40, 0
    v_mov_b32 v41, 0
    v_mov_b32 v42, 0
    v_mov_b32 v43, 0
    v_mov_b32 v44, 0
    v_mov_b32 v45, 0
    v_mov_b32 v46, 0
    v_mov_b32 v47, 0
    v_mov_b32 v48, 0
    v_mov_b32 v49, 0
    v_mov_b32 v50, 0
    v_mov_b32 v51, 0
    v_mov_b32 v52, 0
    v_mov_b32 v53, 0
    v_mov_b32 v54, 0
    v_mov_b32 v55, 0
    v_mov_b32 v150, 0xff800000
    v_mov_b32 v151, 0
    v_mov_b32 v167, 0xf149f2ca
    s_waitcnt lgkmcnt(0)
    s_min_i32 s55, s44, 0x1000
    s_cmp_le_i32 s44, 0
    s_cselect_b32 s55, 0x1000, s55
    s_add_u32 s57, s45, 1024
    s_min_i32 s57, s57, s55
    s_cmp_ge_i32 s45, s57
    s_cbranch_scc1 L_main_done
    s_sub_u32 s46, s57, s45
    s_add_u32 s46, s46, 31
    s_lshr_b32 s46, s46, 5
    s_sub_i32 s53, s44, s45
    s_mov_b32 s47, 0
    s_mov_b32 s56, 0
    s_waitcnt vmcnt(4)
    v_readlane_b32 s49, v148, s48
    s_add_u32 s48, s48, 2
    s_nop 0
    s_lshl_b32 s49, s49, 14
    s_add_u32 s49, s49, s50
    s_cmp_lt_u32 s56, s46
    s_cselect_b32 s49, s49, s51
    s_add_u32 s56, s56, 1
    s_add_u32 m0, s52, 0x0
    s_nop 0
    buffer_load_dwordx4 v144, s[20:23], s49 offen nt lds
    s_add_u32 m0, s52, 0x400
    s_nop 0
    buffer_load_dwordx4 v145, s[20:23], s49 offen nt lds
    s_add_u32 m0, s52, 0x2000
    s_nop 0
    buffer_load_dwordx4 v146, s[24:27], s49 offen nt lds
    s_add_u32 m0, s52, 0x2400
    s_nop 0
    buffer_load_dwordx4 v147, s[24:27], s49 offen nt lds
    v_readlane_b32 s49, v148, s48
    s_add_u32 s48, s48, 2
    s_nop 0
    s_lshl_b32 s49, s49, 14
    s_add_u32 s49, s49, s50
    s_cmp_lt_u32 s56, s46
    s_cselect_b32 s49, s49, s51
    s_add_u32 s56, s56, 1
    s_add_u32 m0, s52, 0x4000
    s_nop 0
    buffer_load_dwordx4 v144, s[20:23], s49 offen nt lds
    s_add_u32 m0, s52, 0x4400
    s_nop 0
    buffer_load_dwordx4 v145, s[20:23], s49 offen nt lds
    s_add_u32 m0, s52, 0x6000
    s_nop 0
    buffer_load_dwordx4 v146, s[24:27], s49 offen nt lds
    s_add_u32 m0, s52, 0x6400
    s_nop 0
    buffer_load_dwordx4 v147, s[24:27], s49 offen nt lds
    s_waitcnt vmcnt(4)
L_loop:
    s_waitcnt vmcnt(4)
    s_barrier
    v_readlane_b32 s49, v148, s48
    s_add_u32 s48, s48, 2
    s_nop 0
    s_lshl_b32 s49, s49, 14
    s_add_u32 s49, s49, s50
    s_cmp_lt_u32 s56, s46
    s_cselect_b32 s49, s49, s51
    s_add_u32 s56, s56, 1
    s_add_u32 m0, s52, 0x8000
    s_nop 0
    buffer_load_dwordx4 v144, s[20:23], s49 offen nt lds
    s_add_u32 m0, s52, 0x8400
    s_nop 0
    buffer_load_dwordx4 v145, s[20:23], s49 offen nt lds
    s_add_u32 m0, s52, 0xa000
    s_nop 0
    buffer_load_dwordx4 v146, s[24:27], s49 offen nt lds
    s_add_u32 m0, s52, 0xa400
    s_nop 0
    buffer_load_dwordx4 v147, s[24:27], s49 offen nt lds
    ds_read_b128 v[64:67], v132 offset:0
    ds_read_b128 v[68:71], v133 offset:0
    ds_read_b128 v[72:75], v134 offset:0
    ds_read_b128 v[76:79], v135 offset:0
    ds_read_b128 v[80:83], v132 offset:4096
    ds_read_b128 v[84:87], v133 offset:4096
    ds_read_b128 v[88:91], v134 offset:4096
    ds_read_b128 v[92:95], v135 offset:4096
    s_waitcnt lgkmcnt(7)
    v_mfma_f32_16x16x32_bf16 v[56:59], v[64:67], v[8:11], 0
    s_waitcnt lgkmcnt(6)
    v_mfma_f32_16x16x32_bf16 v[56:59], v[68:71], v[12:15], v[56:59]
    s_waitcnt lgkmcnt(5)
    v_mfma_f32_16x16x32_bf16 v[56:59], v[72:75], v[16:19], v[56:59]
    s_waitcnt lgkmcnt(4)
    v_mfma_f32_16x16x32_bf16 v[56:59], v[76:79], v[20:23], v[56:59]
    s_waitcnt lgkmcnt(3)
    v_mfma_f32_16x16x32_bf16 v[60:63], v[80:83], v[8:11], 0
    s_waitcnt lgkmcnt(2)
    v_mfma_f32_16x16x32_bf16 v[60:63], v[84:87], v[12:15], v[60:63]
    s_waitcnt lgkmcnt(1)
    v_mfma_f32_16x16x32_bf16 v[60:63], v[88:91], v[16:19], v[60:63]
    s_waitcnt lgkmcnt(0)
    v_mfma_f32_16x16x32_bf16 v[60:63], v[92:95], v[20:23], v[60:63]
    ds_read_b64_tr_b16 v[96:97], v136 offset:8192
    ds_read_b64_tr_b16 v[98:99], v136 offset:12288
    ds_read_b64_tr_b16 v[100:101], v137 offset:8192
    ds_read_b64_tr_b16 v[102:103], v137 offset:12288
    ds_read_b64_tr_b16 v[104:105], v138 offset:8192
    ds_read_b64_tr_b16 v[106:107], v138 offset:12288
    ds_read_b64_tr_b16 v[108:109], v139 offset:8192
    ds_read_b64_tr_b16 v[110:111], v139 offset:12288
    ds_read_b64_tr_b16 v[112:113], v140 offset:8192
    ds_read_b64_tr_b16 v[114:115], v140 offset:12288
    ds_read_b64_tr_b16 v[116:117], v141 offset:8192
    ds_read_b64_tr_b16 v[118:119], v141 offset:12288
    ds_read_b64_tr_b16 v[120:121], v142 offset:8192
    ds_read_b64_tr_b16 v[122:123], v142 offset:12288
    ds_read_b64_tr_b16 v[124:125], v143 offset:8192
    ds_read_b64_tr_b16 v[126:127], v143 offset:12288
    s_cmp_lt_i32 s53, 32
    s_cbranch_scc1 L_msk0
    v_max3_f32 v154, v56, v57, v58
    v_max3_f32 v155, v59, v60, v61
    v_max3_f32 v154, v154, v62, v63
    v_max_f32 v154, v154, v155
    v_mov_b32 v155, v154
    s_nop 1
    v_permlane32_swap_b32 v155, v154
    v_max_f32 v154, v154, v155
    v_mov_b32 v155, v154
    s_nop 1
    v_permlane16_swap_b32 v155, v154
    v_max_f32 v154, v154, v155
    v_mul_f32 v154, s54, v154
    v_max_f32 v156, v150, v154
    v_sub_f32 v157, v150, v156
    v_exp_f32 v152, v157
    v_mov_b32 v150, v156
    v_fma_f32 v56, v56, s54, -v156
    v_fma_f32 v57, v57, s54, -v156
    v_fma_f32 v58, v58, s54, -v156
    v_fma_f32 v59, v59, s54, -v156
    v_fma_f32 v60, v60, s54, -v156
    v_fma_f32 v61, v61, s54, -v156
    v_fma_f32 v62, v62, s54, -v156
    v_fma_f32 v63, v63, s54, -v156
    v_exp_f32 v56, v56
    v_exp_f32 v57, v57
    v_exp_f32 v58, v58
    v_exp_f32 v59, v59
    v_exp_f32 v60, v60
    v_exp_f32 v61, v61
    v_exp_f32 v62, v62
    v_exp_f32 v63, v63
    v_cvt_pk_bf16_f32 v128, v56, v57
    v_cvt_pk_bf16_f32 v129, v58, v59
    v_cvt_pk_bf16_f32 v130, v60, v61
    v_cvt_pk_bf16_f32 v131, v62, v63
    v_add_f32 v154, v56, v57
    v_add_f32 v155, v58, v59
    v_add_f32 v156, v60, v61
    v_add_f32 v157, v62, v63
    v_add_f32 v154, v154, v155
    v_add_f32 v156, v156, v157
    v_add_f32 v154, v154, v156
    v_fma_f32 v151, v151, v152, v154
    v_mul_f32 v24, v152, v24
    v_mul_f32 v25, v152, v25
    v_mul_f32 v26, v152, v26
    v_mul_f32 v27, v152, v27
    v_mul_f32 v28, v152, v28
    v_mul_f32 v29, v152, v29
    v_mul_f32 v30, v152, v30
    v_mul_f32 v31, v152, v31
    v_mul_f32 v32, v152, v32
    v_mul_f32 v33, v152, v33
    v_mul_f32 v34, v152, v34
    v_mul_f32 v35, v152, v35
    v_mul_f32 v36, v152, v36
    v_mul_f32 v37, v152, v37
    v_mul_f32 v38, v152, v38
    v_mul_f32 v39, v152, v39
    v_mul_f32 v40, v152, v40
    v_mul_f32 v41, v152, v41
    v_mul_f32 v42, v152, v42
    v_mul_f32 v43, v152, v43
    v_mul_f32 v44, v152, v44
    v_mul_f32 v45, v152, v45
    v_mul_f32 v46, v152, v46
    v_mul_f32 v47, v152, v47
    v_mul_f32 v48, v152, v48
    v_mul_f32 v49, v152, v49
    v_mul_f32 v50, v152, v50
    v_mul_f32 v51, v152, v51
    v_mul_f32 v52, v152, v52
    v_mul_f32 v53, v152, v53
    v_mul_f32 v54, v152, v54
    v_mul_f32 v55, v152, v55
    s_branch L_pv0
L_msk0:
    v_mul_f32 v56, s54, v56
    s_sub_i32 s3, s53, 0
    v_cmp_gt_i32 vcc, s3, v166
    s_nop 1
    v_cndmask_b32 v56, v167, v56, vcc
    v_mul_f32 v57, s54, v57
    s_sub_i32 s3, s53, 1
    v_cmp_gt_i32 vcc, s3, v166
    s_nop 1
    v_cndmask_b32 v57, v167, v57, vcc
    v_mul_f32 v58, s54, v58
    s_sub_i32 s3, s53, 2
    v_cmp_gt_i32 vcc, s3, v166
    s_nop 1
    v_cndmask_b32 v58, v167, v58, vcc
    v_mul_f32 v59, s54, v59
    s_sub_i32 s3, s53, 3
    v_cmp_gt_i32 vcc, s3, v166
    s_nop 1
    v_cndmask_b32 v59, v167, v59, vcc
    v_mul_f32 v60, s54, v60
    s_sub_i32 s3, s53, 16
    v_cmp_gt_i32 vcc, s3, v166
    s_nop 1
    v_cndmask_b32 v60, v167, v60, vcc
    v_mul_f32 v61, s54, v61
    s_sub_i32 s3, s53, 17
    v_cmp_gt_i32 vcc, s3, v166
    s_nop 1
    v_cndmask_b32 v61, v167, v61, vcc
    v_mul_f32 v62, s54, v62
    s_sub_i32 s3, s53, 18
    v_cmp_gt_i32 vcc, s3, v166
    s_nop 1
    v_cndmask_b32 v62, v167, v62, vcc
    v_mul_f32 v63, s54, v63
    s_sub_i32 s3, s53, 19
    v_cmp_gt_i32 vcc, s3, v166
    s_nop 1
    v_cndmask_b32 v63, v167, v63, vcc
    v_max3_f32 v154, v56, v57, v58
    v_max3_f32 v155, v59, v60, v61
    v_max3_f32 v154, v154, v62, v63
    v_max_f32 v154, v154, v155
    v_mov_b32 v155, v154
    s_nop 1
    v_permlane32_swap_b32 v155, v154
    v_max_f32 v154, v154, v155
    v_mov_b32 v155, v154
    s_nop 1
    v_permlane16_swap_b32 v155, v154
    v_max_f32 v154, v154, v155
    v_max_f32 v156, v150, v154
    v_sub_f32 v157, v150, v156
    v_exp_f32 v152, v157
    v_mov_b32 v150, v156
    v_sub_f32 v56, v56, v156
    v_sub_f32 v57, v57, v156
    v_sub_f32 v58, v58, v156
    v_sub_f32 v59, v59, v156
    v_sub_f32 v60, v60, v156
    v_sub_f32 v61, v61, v156
    v_sub_f32 v62, v62, v156
    v_sub_f32 v63, v63, v156
    v_exp_f32 v56, v56
    v_exp_f32 v57, v57
    v_exp_f32 v58, v58
    v_exp_f32 v59, v59
    v_exp_f32 v60, v60
    v_exp_f32 v61, v61
    v_exp_f32 v62, v62
    v_exp_f32 v63, v63
    v_cvt_pk_bf16_f32 v128, v56, v57
    v_cvt_pk_bf16_f32 v129, v58, v59
    v_cvt_pk_bf16_f32 v130, v60, v61
    v_cvt_pk_bf16_f32 v131, v62, v63
    v_add_f32 v154, v56, v57
    v_add_f32 v155, v58, v59
    v_add_f32 v156, v60, v61
    v_add_f32 v157, v62, v63
    v_add_f32 v154, v154, v155
    v_add_f32 v156, v156, v157
    v_add_f32 v154, v154, v156
    v_fma_f32 v151, v151, v152, v154
    v_mul_f32 v24, v152, v24
    v_mul_f32 v25, v152, v25
    v_mul_f32 v26, v152, v26
    v_mul_f32 v27, v152, v27
    v_mul_f32 v28, v152, v28
    v_mul_f32 v29, v152, v29
    v_mul_f32 v30, v152, v30
    v_mul_f32 v31, v152, v31
    v_mul_f32 v32, v152, v32
    v_mul_f32 v33, v152, v33
    v_mul_f32 v34, v152, v34
    v_mul_f32 v35, v152, v35
    v_mul_f32 v36, v152, v36
    v_mul_f32 v37, v152, v37
    v_mul_f32 v38, v152, v38
    v_mul_f32 v39, v152, v39
    v_mul_f32 v40, v152, v40
    v_mul_f32 v41, v152, v41
    v_mul_f32 v42, v152, v42
    v_mul_f32 v43, v152, v43
    v_mul_f32 v44, v152, v44
    v_mul_f32 v45, v152, v45
    v_mul_f32 v46, v152, v46
    v_mul_f32 v47, v152, v47
    v_mul_f32 v48, v152, v48
    v_mul_f32 v49, v152, v49
    v_mul_f32 v50, v152, v50
    v_mul_f32 v51, v152, v51
    v_mul_f32 v52, v152, v52
    v_mul_f32 v53, v152, v53
    v_mul_f32 v54, v152, v54
    v_mul_f32 v55, v152, v55
L_pv0:
    s_waitcnt lgkmcnt(0)
    v_mfma_f32_16x16x32_bf16 v[24:27], v[96:99], v[128:131], v[24:27]
    v_mfma_f32_16x16x32_bf16 v[28:31], v[100:103], v[128:131], v[28:31]
    v_mfma_f32_16x16x32_bf16 v[32:35], v[104:107], v[128:131], v[32:35]
    v_mfma_f32_16x16x32_bf16 v[36:39], v[108:111], v[128:131], v[36:39]
    v_mfma_f32_16x16x32_bf16 v[40:43], v[112:115], v[128:131], v[40:43]
    v_mfma_f32_16x16x32_bf16 v[44:47], v[116:119], v[128:131], v[44:47]
    v_mfma_f32_16x16x32_bf16 v[48:51], v[120:123], v[128:131], v[48:51]
    v_mfma_f32_16x16x32_bf16 v[52:55], v[124:127], v[128:131], v[52:55]
    s_sub_i32 s53, s53, 32
    s_add_u32 s47, s47, 1
    s_cmp_ge_u32 s47, s46
    s_cbranch_scc1 L_epi
    s_waitcnt vmcnt(4)
    s_barrier
    v_readlane_b32 s49, v148, s48
    s_add_u32 s48, s48, 2
    s_nop 0
    s_lshl_b32 s49, s49, 14
    s_add_u32 s49, s49, s50
    s_cmp_lt_u32 s56, s46
    s_cselect_b32 s49, s49, s51
    s_add_u32 s56, s56, 1
    s_add_u32 m0, s52, 0x0
    s_nop 0
    buffer_load_dwordx4 v144, s[20:23], s49 offen nt lds
    s_add_u32 m0, s52, 0x400
    s_nop 0
    buffer_load_dwordx4 v145, s[20:23], s49 offen nt lds
    s_add_u32 m0, s52, 0x2000
    s_nop 0
    buffer_load_dwordx4 v146, s[24:27], s49 offen nt lds
    s_add_u32 m0, s52, 0x2400
    s_nop 0
    buffer_load_dwordx4 v147, s[24:27], s49 offen nt lds
    ds_read_b128 v[64:67], v132 offset:16384
    ds_read_b128 v[68:71], v133 offset:16384
    ds_read_b128 v[72:75], v134 offset:16384
    ds_read_b128 v[76:79], v135 offset:16384
    ds_read_b128 v[80:83], v132 offset:20480
    ds_read_b128 v[84:87], v133 offset:20480
    ds_read_b128 v[88:91], v134 offset:20480
    ds_read_b128 v[92:95], v135 offset:20480
    s_waitcnt lgkmcnt(7)
    v_mfma_f32_16x16x32_bf16 v[56:59], v[64:67], v[8:11], 0
    s_waitcnt lgkmcnt(6)
    v_mfma_f32_16x16x32_bf16 v[56:59], v[68:71], v[12:15], v[56:59]
    s_waitcnt lgkmcnt(5)
    v_mfma_f32_16x16x32_bf16 v[56:59], v[72:75], v[16:19], v[56:59]
    s_waitcnt lgkmcnt(4)
    v_mfma_f32_16x16x32_bf16 v[56:59], v[76:79], v[20:23], v[56:59]
    s_waitcnt lgkmcnt(3)
    v_mfma_f32_16x16x32_bf16 v[60:63], v[80:83], v[8:11], 0
    s_waitcnt lgkmcnt(2)
    v_mfma_f32_16x16x32_bf16 v[60:63], v[84:87], v[12:15], v[60:63]
    s_waitcnt lgkmcnt(1)
    v_mfma_f32_16x16x32_bf16 v[60:63], v[88:91], v[16:19], v[60:63]
    s_waitcnt lgkmcnt(0)
    v_mfma_f32_16x16x32_bf16 v[60:63], v[92:95], v[20:23], v[60:63]
    ds_read_b64_tr_b16 v[96:97], v136 offset:24576
    ds_read_b64_tr_b16 v[98:99], v136 offset:28672
    ds_read_b64_tr_b16 v[100:101], v137 offset:24576
    ds_read_b64_tr_b16 v[102:103], v137 offset:28672
    ds_read_b64_tr_b16 v[104:105], v138 offset:24576
    ds_read_b64_tr_b16 v[106:107], v138 offset:28672
    ds_read_b64_tr_b16 v[108:109], v139 offset:24576
    ds_read_b64_tr_b16 v[110:111], v139 offset:28672
    ds_read_b64_tr_b16 v[112:113], v140 offset:24576
    ds_read_b64_tr_b16 v[114:115], v140 offset:28672
    ds_read_b64_tr_b16 v[116:117], v141 offset:24576
    ds_read_b64_tr_b16 v[118:119], v141 offset:28672
    ds_read_b64_tr_b16 v[120:121], v142 offset:24576
    ds_read_b64_tr_b16 v[122:123], v142 offset:28672
    ds_read_b64_tr_b16 v[124:125], v143 offset:24576
    ds_read_b64_tr_b16 v[126:127], v143 offset:28672
    s_cmp_lt_i32 s53, 32
    s_cbranch_scc1 L_msk1
    v_max3_f32 v154, v56, v57, v58
    v_max3_f32 v155, v59, v60, v61
    v_max3_f32 v154, v154, v62, v63
    v_max_f32 v154, v154, v155
    v_mov_b32 v155, v154
    s_nop 1
    v_permlane32_swap_b32 v155, v154
    v_max_f32 v154, v154, v155
    v_mov_b32 v155, v154
    s_nop 1
    v_permlane16_swap_b32 v155, v154
    v_max_f32 v154, v154, v155
    v_mul_f32 v154, s54, v154
    v_max_f32 v156, v150, v154
    v_sub_f32 v157, v150, v156
    v_exp_f32 v152, v157
    v_mov_b32 v150, v156
    v_fma_f32 v56, v56, s54, -v156
    v_fma_f32 v57, v57, s54, -v156
    v_fma_f32 v58, v58, s54, -v156
    v_fma_f32 v59, v59, s54, -v156
    v_fma_f32 v60, v60, s54, -v156
    v_fma_f32 v61, v61, s54, -v156
    v_fma_f32 v62, v62, s54, -v156
    v_fma_f32 v63, v63, s54, -v156
    v_exp_f32 v56, v56
    v_exp_f32 v57, v57
    v_exp_f32 v58, v58
    v_exp_f32 v59, v59
    v_exp_f32 v60, v60
    v_exp_f32 v61, v61
    v_exp_f32 v62, v62
    v_exp_f32 v63, v63
    v_cvt_pk_bf16_f32 v128, v56, v57
    v_cvt_pk_bf16_f32 v129, v58, v59
    v_cvt_pk_bf16_f32 v130, v60, v61
    v_cvt_pk_bf16_f32 v131, v62, v63
    v_add_f32 v154, v56, v57
    v_add_f32 v155, v58, v59
    v_add_f32 v156, v60, v61
    v_add_f32 v157, v62, v63
    v_add_f32 v154, v154, v155
    v_add_f32 v156, v156, v157
    v_add_f32 v154, v154, v156
    v_fma_f32 v151, v151, v152, v154
    v_mul_f32 v24, v152, v24
    v_mul_f32 v25, v152, v25
    v_mul_f32 v26, v152, v26
    v_mul_f32 v27, v152, v27
    v_mul_f32 v28, v152, v28
    v_mul_f32 v29, v152, v29
    v_mul_f32 v30, v152, v30
    v_mul_f32 v31, v152, v31
    v_mul_f32 v32, v152, v32
    v_mul_f32 v33, v152, v33
    v_mul_f32 v34, v152, v34
    v_mul_f32 v35, v152, v35
    v_mul_f32 v36, v152, v36
    v_mul_f32 v37, v152, v37
    v_mul_f32 v38, v152, v38
    v_mul_f32 v39, v152, v39
    v_mul_f32 v40, v152, v40
    v_mul_f32 v41, v152, v41
    v_mul_f32 v42, v152, v42
    v_mul_f32 v43, v152, v43
    v_mul_f32 v44, v152, v44
    v_mul_f32 v45, v152, v45
    v_mul_f32 v46, v152, v46
    v_mul_f32 v47, v152, v47
    v_mul_f32 v48, v152, v48
    v_mul_f32 v49, v152, v49
    v_mul_f32 v50, v152, v50
    v_mul_f32 v51, v152, v51
    v_mul_f32 v52, v152, v52
    v_mul_f32 v53, v152, v53
    v_mul_f32 v54, v152, v54
    v_mul_f32 v55, v152, v55
    s_branch L_pv1
L_msk1:
    v_mul_f32 v56, s54, v56
    s_sub_i32 s3, s53, 0
    v_cmp_gt_i32 vcc, s3, v166
    s_nop 1
    v_cndmask_b32 v56, v167, v56, vcc
    v_mul_f32 v57, s54, v57
    s_sub_i32 s3, s53, 1
    v_cmp_gt_i32 vcc, s3, v166
    s_nop 1
    v_cndmask_b32 v57, v167, v57, vcc
    v_mul_f32 v58, s54, v58
    s_sub_i32 s3, s53, 2
    v_cmp_gt_i32 vcc, s3, v166
    s_nop 1
    v_cndmask_b32 v58, v167, v58, vcc
    v_mul_f32 v59, s54, v59
    s_sub_i32 s3, s53, 3
    v_cmp_gt_i32 vcc, s3, v166
    s_nop 1
    v_cndmask_b32 v59, v167, v59, vcc
    v_mul_f32 v60, s54, v60
    s_sub_i32 s3, s53, 16
    v_cmp_gt_i32 vcc, s3, v166
    s_nop 1
    v_cndmask_b32 v60, v167, v60, vcc
    v_mul_f32 v61, s54, v61
    s_sub_i32 s3, s53, 17
    v_cmp_gt_i32 vcc, s3, v166
    s_nop 1
    v_cndmask_b32 v61, v167, v61, vcc
    v_mul_f32 v62, s54, v62
    s_sub_i32 s3, s53, 18
    v_cmp_gt_i32 vcc, s3, v166
    s_nop 1
    v_cndmask_b32 v62, v167, v62, vcc
    v_mul_f32 v63, s54, v63
    s_sub_i32 s3, s53, 19
    v_cmp_gt_i32 vcc, s3, v166
    s_nop 1
    v_cndmask_b32 v63, v167, v63, vcc
    v_max3_f32 v154, v56, v57, v58
    v_max3_f32 v155, v59, v60, v61
    v_max3_f32 v154, v154, v62, v63
    v_max_f32 v154, v154, v155
    v_mov_b32 v155, v154
    s_nop 1
    v_permlane32_swap_b32 v155, v154
    v_max_f32 v154, v154, v155
    v_mov_b32 v155, v154
    s_nop 1
    v_permlane16_swap_b32 v155, v154
    v_max_f32 v154, v154, v155
    v_max_f32 v156, v150, v154
    v_sub_f32 v157, v150, v156
    v_exp_f32 v152, v157
    v_mov_b32 v150, v156
    v_sub_f32 v56, v56, v156
    v_sub_f32 v57, v57, v156
    v_sub_f32 v58, v58, v156
    v_sub_f32 v59, v59, v156
    v_sub_f32 v60, v60, v156
    v_sub_f32 v61, v61, v156
    v_sub_f32 v62, v62, v156
    v_sub_f32 v63, v63, v156
    v_exp_f32 v56, v56
    v_exp_f32 v57, v57
    v_exp_f32 v58, v58
    v_exp_f32 v59, v59
    v_exp_f32 v60, v60
    v_exp_f32 v61, v61
    v_exp_f32 v62, v62
    v_exp_f32 v63, v63
    v_cvt_pk_bf16_f32 v128, v56, v57
    v_cvt_pk_bf16_f32 v129, v58, v59
    v_cvt_pk_bf16_f32 v130, v60, v61
    v_cvt_pk_bf16_f32 v131, v62, v63
    v_add_f32 v154, v56, v57
    v_add_f32 v155, v58, v59
    v_add_f32 v156, v60, v61
    v_add_f32 v157, v62, v63
    v_add_f32 v154, v154, v155
    v_add_f32 v156, v156, v157
    v_add_f32 v154, v154, v156
    v_fma_f32 v151, v151, v152, v154
    v_mul_f32 v24, v152, v24
    v_mul_f32 v25, v152, v25
    v_mul_f32 v26, v152, v26
    v_mul_f32 v27, v152, v27
    v_mul_f32 v28, v152, v28
    v_mul_f32 v29, v152, v29
    v_mul_f32 v30, v152, v30
    v_mul_f32 v31, v152, v31
    v_mul_f32 v32, v152, v32
    v_mul_f32 v33, v152, v33
    v_mul_f32 v34, v152, v34
    v_mul_f32 v35, v152, v35
    v_mul_f32 v36, v152, v36
    v_mul_f32 v37, v152, v37
    v_mul_f32 v38, v152, v38
    v_mul_f32 v39, v152, v39
    v_mul_f32 v40, v152, v40
    v_mul_f32 v41, v152, v41
    v_mul_f32 v42, v152, v42
    v_mul_f32 v43, v152, v43
    v_mul_f32 v44, v152, v44
    v_mul_f32 v45, v152, v45
    v_mul_f32 v46, v152, v46
    v_mul_f32 v47, v152, v47
    v_mul_f32 v48, v152, v48
    v_mul_f32 v49, v152, v49
    v_mul_f32 v50, v152, v50
    v_mul_f32 v51, v152, v51
    v_mul_f32 v52, v152, v52
    v_mul_f32 v53, v152, v53
    v_mul_f32 v54, v152, v54
    v_mul_f32 v55, v152, v55
L_pv1:
    s_waitcnt lgkmcnt(0)
    v_mfma_f32_16x16x32_bf16 v[24:27], v[96:99], v[128:131], v[24:27]
    v_mfma_f32_16x16x32_bf16 v[28:31], v[100:103], v[128:131], v[28:31]
    v_mfma_f32_16x16x32_bf16 v[32:35], v[104:107], v[128:131], v[32:35]
    v_mfma_f32_16x16x32_bf16 v[36:39], v[108:111], v[128:131], v[36:39]
    v_mfma_f32_16x16x32_bf16 v[40:43], v[112:115], v[128:131], v[40:43]
    v_mfma_f32_16x16x32_bf16 v[44:47], v[116:119], v[128:131], v[44:47]
    v_mfma_f32_16x16x32_bf16 v[48:51], v[120:123], v[128:131], v[48:51]
    v_mfma_f32_16x16x32_bf16 v[52:55], v[124:127], v[128:131], v[52:55]
    s_sub_i32 s53, s53, 32
    s_add_u32 s47, s47, 1
    s_cmp_ge_u32 s47, s46
    s_cbranch_scc1 L_epi
    s_waitcnt vmcnt(4)
    s_barrier
    v_readlane_b32 s49, v148, s48
    s_add_u32 s48, s48, 2
    s_nop 0
    s_lshl_b32 s49, s49, 14
    s_add_u32 s49, s49, s50
    s_cmp_lt_u32 s56, s46
    s_cselect_b32 s49, s49, s51
    s_add_u32 s56, s56, 1
    s_add_u32 m0, s52, 0x4000
    s_nop 0
    buffer_load_dwordx4 v144, s[20:23], s49 offen nt lds
    s_add_u32 m0, s52, 0x4400
    s_nop 0
    buffer_load_dwordx4 v145, s[20:23], s49 offen nt lds
    s_add_u32 m0, s52, 0x6000
    s_nop 0
    buffer_load_dwordx4 v146, s[24:27], s49 offen nt lds
    s_add_u32 m0, s52, 0x6400
    s_nop 0
    buffer_load_dwordx4 v147, s[24:27], s49 offen nt lds
    ds_read_b128 v[64:67], v132 offset:32768
    ds_read_b128 v[68:71], v133 offset:32768
    ds_read_b128 v[72:75], v134 offset:32768
    ds_read_b128 v[76:79], v135 offset:32768
    ds_read_b128 v[80:83], v132 offset:36864
    ds_read_b128 v[84:87], v133 offset:36864
    ds_read_b128 v[88:91], v134 offset:36864
    ds_read_b128 v[92:95], v135 offset:36864
    s_waitcnt lgkmcnt(7)
    v_mfma_f32_16x16x32_bf16 v[56:59], v[64:67], v[8:11], 0
    s_waitcnt lgkmcnt(6)
    v_mfma_f32_16x16x32_bf16 v[56:59], v[68:71], v[12:15], v[56:59]
    s_waitcnt lgkmcnt(5)
    v_mfma_f32_16x16x32_bf16 v[56:59], v[72:75], v[16:19], v[56:59]
    s_waitcnt lgkmcnt(4)
    v_mfma_f32_16x16x32_bf16 v[56:59], v[76:79], v[20:23], v[56:59]
    s_waitcnt lgkmcnt(3)
    v_mfma_f32_16x16x32_bf16 v[60:63], v[80:83], v[8:11], 0
    s_waitcnt lgkmcnt(2)
    v_mfma_f32_16x16x32_bf16 v[60:63], v[84:87], v[12:15], v[60:63]
    s_waitcnt lgkmcnt(1)
    v_mfma_f32_16x16x32_bf16 v[60:63], v[88:91], v[16:19], v[60:63]
    s_waitcnt lgkmcnt(0)
    v_mfma_f32_16x16x32_bf16 v[60:63], v[92:95], v[20:23], v[60:63]
    ds_read_b64_tr_b16 v[96:97], v136 offset:40960
    ds_read_b64_tr_b16 v[98:99], v136 offset:45056
    ds_read_b64_tr_b16 v[100:101], v137 offset:40960
    ds_read_b64_tr_b16 v[102:103], v137 offset:45056
    ds_read_b64_tr_b16 v[104:105], v138 offset:40960
    ds_read_b64_tr_b16 v[106:107], v138 offset:45056
    ds_read_b64_tr_b16 v[108:109], v139 offset:40960
    ds_read_b64_tr_b16 v[110:111], v139 offset:45056
    ds_read_b64_tr_b16 v[112:113], v140 offset:40960
    ds_read_b64_tr_b16 v[114:115], v140 offset:45056
    ds_read_b64_tr_b16 v[116:117], v141 offset:40960
    ds_read_b64_tr_b16 v[118:119], v141 offset:45056
    ds_read_b64_tr_b16 v[120:121], v142 offset:40960
    ds_read_b64_tr_b16 v[122:123], v142 offset:45056
    ds_read_b64_tr_b16 v[124:125], v143 offset:40960
    ds_read_b64_tr_b16 v[126:127], v143 offset:45056
    s_cmp_lt_i32 s53, 32
    s_cbranch_scc1 L_msk2
    v_max3_f32 v154, v56, v57, v58
    v_max3_f32 v155, v59, v60, v61
    v_max3_f32 v154, v154, v62, v63
    v_max_f32 v154, v154, v155
    v_mov_b32 v155, v154
    s_nop 1
    v_permlane32_swap_b32 v155, v154
    v_max_f32 v154, v154, v155
    v_mov_b32 v155, v154
    s_nop 1
    v_permlane16_swap_b32 v155, v154
    v_max_f32 v154, v154, v155
    v_mul_f32 v154, s54, v154
    v_max_f32 v156, v150, v154
    v_sub_f32 v157, v150, v156
    v_exp_f32 v152, v157
    v_mov_b32 v150, v156
    v_fma_f32 v56, v56, s54, -v156
    v_fma_f32 v57, v57, s54, -v156
    v_fma_f32 v58, v58, s54, -v156
    v_fma_f32 v59, v59, s54, -v156
    v_fma_f32 v60, v60, s54, -v156
    v_fma_f32 v61, v61, s54, -v156
    v_fma_f32 v62, v62, s54, -v156
    v_fma_f32 v63, v63, s54, -v156
    v_exp_f32 v56, v56
    v_exp_f32 v57, v57
    v_exp_f32 v58, v58
    v_exp_f32 v59, v59
    v_exp_f32 v60, v60
    v_exp_f32 v61, v61
    v_exp_f32 v62, v62
    v_exp_f32 v63, v63
    v_cvt_pk_bf16_f32 v128, v56, v57
    v_cvt_pk_bf16_f32 v129, v58, v59
    v_cvt_pk_bf16_f32 v130, v60, v61
    v_cvt_pk_bf16_f32 v131, v62, v63
    v_add_f32 v154, v56, v57
    v_add_f32 v155, v58, v59
    v_add_f32 v156, v60, v61
    v_add_f32 v157, v62, v63
    v_add_f32 v154, v154, v155
    v_add_f32 v156, v156, v157
    v_add_f32 v154, v154, v156
    v_fma_f32 v151, v151, v152, v154
    v_mul_f32 v24, v152, v24
    v_mul_f32 v25, v152, v25
    v_mul_f32 v26, v152, v26
    v_mul_f32 v27, v152, v27
    v_mul_f32 v28, v152, v28
    v_mul_f32 v29, v152, v29
    v_mul_f32 v30, v152, v30
    v_mul_f32 v31, v152, v31
    v_mul_f32 v32, v152, v32
    v_mul_f32 v33, v152, v33
    v_mul_f32 v34, v152, v34
    v_mul_f32 v35, v152, v35
    v_mul_f32 v36, v152, v36
    v_mul_f32 v37, v152, v37
    v_mul_f32 v38, v152, v38
    v_mul_f32 v39, v152, v39
    v_mul_f32 v40, v152, v40
    v_mul_f32 v41, v152, v41
    v_mul_f32 v42, v152, v42
    v_mul_f32 v43, v152, v43
    v_mul_f32 v44, v152, v44
    v_mul_f32 v45, v152, v45
    v_mul_f32 v46, v152, v46
    v_mul_f32 v47, v152, v47
    v_mul_f32 v48, v152, v48
    v_mul_f32 v49, v152, v49
    v_mul_f32 v50, v152, v50
    v_mul_f32 v51, v152, v51
    v_mul_f32 v52, v152, v52
    v_mul_f32 v53, v152, v53
    v_mul_f32 v54, v152, v54
    v_mul_f32 v55, v152, v55
    s_branch L_pv2
L_msk2:
    v_mul_f32 v56, s54, v56
    s_sub_i32 s3, s53, 0
    v_cmp_gt_i32 vcc, s3, v166
    s_nop 1
    v_cndmask_b32 v56, v167, v56, vcc
    v_mul_f32 v57, s54, v57
    s_sub_i32 s3, s53, 1
    v_cmp_gt_i32 vcc, s3, v166
    s_nop 1
    v_cndmask_b32 v57, v167, v57, vcc
    v_mul_f32 v58, s54, v58
    s_sub_i32 s3, s53, 2
    v_cmp_gt_i32 vcc, s3, v166
    s_nop 1
    v_cndmask_b32 v58, v167, v58, vcc
    v_mul_f32 v59, s54, v59
    s_sub_i32 s3, s53, 3
    v_cmp_gt_i32 vcc, s3, v166
    s_nop 1
    v_cndmask_b32 v59, v167, v59, vcc
    v_mul_f32 v60, s54, v60
    s_sub_i32 s3, s53, 16
    v_cmp_gt_i32 vcc, s3, v166
    s_nop 1
    v_cndmask_b32 v60, v167, v60, vcc
    v_mul_f32 v61, s54, v61
    s_sub_i32 s3, s53, 17
    v_cmp_gt_i32 vcc, s3, v166
    s_nop 1
    v_cndmask_b32 v61, v167, v61, vcc
    v_mul_f32 v62, s54, v62
    s_sub_i32 s3, s53, 18
    v_cmp_gt_i32 vcc, s3, v166
    s_nop 1
    v_cndmask_b32 v62, v167, v62, vcc
    v_mul_f32 v63, s54, v63
    s_sub_i32 s3, s53, 19
    v_cmp_gt_i32 vcc, s3, v166
    s_nop 1
    v_cndmask_b32 v63, v167, v63, vcc
    v_max3_f32 v154, v56, v57, v58
    v_max3_f32 v155, v59, v60, v61
    v_max3_f32 v154, v154, v62, v63
    v_max_f32 v154, v154, v155
    v_mov_b32 v155, v154
    s_nop 1
    v_permlane32_swap_b32 v155, v154
    v_max_f32 v154, v154, v155
    v_mov_b32 v155, v154
    s_nop 1
    v_permlane16_swap_b32 v155, v154
    v_max_f32 v154, v154, v155
    v_max_f32 v156, v150, v154
    v_sub_f32 v157, v150, v156
    v_exp_f32 v152, v157
    v_mov_b32 v150, v156
    v_sub_f32 v56, v56, v156
    v_sub_f32 v57, v57, v156
    v_sub_f32 v58, v58, v156
    v_sub_f32 v59, v59, v156
    v_sub_f32 v60, v60, v156
    v_sub_f32 v61, v61, v156
    v_sub_f32 v62, v62, v156
    v_sub_f32 v63, v63, v156
    v_exp_f32 v56, v56
    v_exp_f32 v57, v57
    v_exp_f32 v58, v58
    v_exp_f32 v59, v59
    v_exp_f32 v60, v60
    v_exp_f32 v61, v61
    v_exp_f32 v62, v62
    v_exp_f32 v63, v63
    v_cvt_pk_bf16_f32 v128, v56, v57
    v_cvt_pk_bf16_f32 v129, v58, v59
    v_cvt_pk_bf16_f32 v130, v60, v61
    v_cvt_pk_bf16_f32 v131, v62, v63
    v_add_f32 v154, v56, v57
    v_add_f32 v155, v58, v59
    v_add_f32 v156, v60, v61
    v_add_f32 v157, v62, v63
    v_add_f32 v154, v154, v155
    v_add_f32 v156, v156, v157
    v_add_f32 v154, v154, v156
    v_fma_f32 v151, v151, v152, v154
    v_mul_f32 v24, v152, v24
    v_mul_f32 v25, v152, v25
    v_mul_f32 v26, v152, v26
    v_mul_f32 v27, v152, v27
    v_mul_f32 v28, v152, v28
    v_mul_f32 v29, v152, v29
    v_mul_f32 v30, v152, v30
    v_mul_f32 v31, v152, v31
    v_mul_f32 v32, v152, v32
    v_mul_f32 v33, v152, v33
    v_mul_f32 v34, v152, v34
    v_mul_f32 v35, v152, v35
    v_mul_f32 v36, v152, v36
    v_mul_f32 v37, v152, v37
    v_mul_f32 v38, v152, v38
    v_mul_f32 v39, v152, v39
    v_mul_f32 v40, v152, v40
    v_mul_f32 v41, v152, v41
    v_mul_f32 v42, v152, v42
    v_mul_f32 v43, v152, v43
    v_mul_f32 v44, v152, v44
    v_mul_f32 v45, v152, v45
    v_mul_f32 v46, v152, v46
    v_mul_f32 v47, v152, v47
    v_mul_f32 v48, v152, v48
    v_mul_f32 v49, v152, v49
    v_mul_f32 v50, v152, v50
    v_mul_f32 v51, v152, v51
    v_mul_f32 v52, v152, v52
    v_mul_f32 v53, v152, v53
    v_mul_f32 v54, v152, v54
    v_mul_f32 v55, v152, v55
L_pv2:
    s_waitcnt lgkmcnt(0)
    v_mfma_f32_16x16x32_bf16 v[24:27], v[96:99], v[128:131], v[24:27]
    v_mfma_f32_16x16x32_bf16 v[28:31], v[100:103], v[128:131], v[28:31]
    v_mfma_f32_16x16x32_bf16 v[32:35], v[104:107], v[128:131], v[32:35]
    v_mfma_f32_16x16x32_bf16 v[36:39], v[108:111], v[128:131], v[36:39]
    v_mfma_f32_16x16x32_bf16 v[40:43], v[112:115], v[128:131], v[40:43]
    v_mfma_f32_16x16x32_bf16 v[44:47], v[116:119], v[128:131], v[44:47]
    v_mfma_f32_16x16x32_bf16 v[48:51], v[120:123], v[128:131], v[48:51]
    v_mfma_f32_16x16x32_bf16 v[52:55], v[124:127], v[128:131], v[52:55]
    s_sub_i32 s53, s53, 32
    s_add_u32 s47, s47, 1
    s_cmp_ge_u32 s47, s46
    s_cbranch_scc1 L_epi
    s_branch L_loop
L_epi:
    v_mov_b32 v154, v151
    s_nop 1
    v_permlane32_swap_b32 v154, v151
    v_add_f32 v151, v151, v154
    v_mov_b32 v154, v151
    s_nop 1
    v_permlane16_swap_b32 v154, v151
    v_add_f32 v151, v151, v154
    v_lshl_add_u32 v2, s43, 4, v3
    v_lshlrev_b32 v5, 9, v2
    v_lshl_add_u32 v5, v4, 4, v5
    s_lshl_b32 s3, s2, 15
    s_nop 7
    buffer_store_dwordx4 v[24:27], v5, s[32:35], s3 offen offset:0
    buffer_store_dwordx4 v[28:31], v5, s[32:35], s3 offen offset:64
    buffer_store_dwordx4 v[32:35], v5, s[32:35], s3 offen offset:128
    buffer_store_dwordx4 v[36:39], v5, s[32:35], s3 offen offset:192
    buffer_store_dwordx4 v[40:43], v5, s[32:35], s3 offen offset:256
    buffer_store_dwordx4 v[44:47], v5, s[32:35], s3 offen offset:320
    buffer_store_dwordx4 v[48:51], v5, s[32:35], s3 offen offset:384
    buffer_store_dwordx4 v[52:55], v5, s[32:35], s3 offen offset:448
    v_lshlrev_b32 v6, 3, v2
    s_lshl_b32 s3, s2, 9
    s_add_u32 s3, s3, 0x800000
    v_cmp_gt_u32 vcc, 16, v1
    s_nop 1
    s_and_saveexec_b64 s[58:59], vcc
    buffer_store_dwordx2 v[150:151], v6, s[32:35], s3 offen
L_main_done:
    s_endpgm
.p2align 8
.globl pa_combine_kernel
.type pa_combine_kernel,@function
pa_combine_kernel:
    s_cmp_ge_u32 s2, 512
    s_cbranch_scc1 L_comb_done
    s_load_dwordx16 s[4:19], s[0:1], 0
    s_lshr_b32 s3, s2, 5
    s_lshl_b32 s3, s3, 2
    v_lshrrev_b32 v2, 6, v0
    v_and_b32 v1, 63, v0
    v_readfirstlane_b32 s43, v2
    s_waitcnt lgkmcnt(0)
    s_load_dword s44, s[12:13], s3
    s_mov_b32 s20, s18
    s_mov_b32 s21, s19
    s_mov_b32 s22, 0x10040000
    s_mov_b32 s23, 0x20000
    s_mov_b32 s24, s14
    s_mov_b32 s25, s15
    s_mov_b32 s26, 0x100000
    s_mov_b32 s27, 0x20000
    v_and_b32 v3, 31, v1
    v_lshrrev_b32 v4, 5, v1
    v_lshl_add_u32 v4, s43, 1, v4
    v_lshlrev_b32 v5, 9, v4
    v_lshl_add_u32 v5, v3, 4, v5
    v_lshlrev_b32 v6, 3, v4
    v_lshlrev_b32 v7, 8, v4
    v_lshl_add_u32 v7, v3, 3, v7
    v_mov_b32 v16, 0
    v_mov_b32 v17, 0
    v_mov_b32 v18, 0
    v_mov_b32 v19, 0
    v_mov_b32 v32, 0xff800000
    v_mov_b32 v33, 0
    v_mov_b32 v20, 0
    v_mov_b32 v21, 0
    v_mov_b32 v22, 0
    v_mov_b32 v23, 0
    v_mov_b32 v34, 0xff800000
    v_mov_b32 v35, 0
    v_mov_b32 v24, 0
    v_mov_b32 v25, 0
    v_mov_b32 v26, 0
    v_mov_b32 v27, 0
    v_mov_b32 v36, 0xff800000
    v_mov_b32 v37, 0
    v_mov_b32 v28, 0
    v_mov_b32 v29, 0
    v_mov_b32 v30, 0
    v_mov_b32 v31, 0
    v_mov_b32 v38, 0xff800000
    v_mov_b32 v39, 0
    s_lshr_b32 s45, s2, 3
    s_and_b32 s3, s45, 3
    s_lshl_b32 s3, s3, 4
    s_lshr_b32 s45, s45, 2
    s_add_u32 s45, s45, s3
    s_and_b32 s46, s2, 7
    s_lshl_b32 s47, s45, 15
    s_lshl_b32 s3, s46, 12
    s_add_u32 s47, s47, s3
    s_lshl_b32 s48, s45, 9
    s_lshl_b32 s3, s46, 6
    s_add_u32 s48, s48, s3
    s_add_u32 s48, s48, 0x800000
    buffer_load_dwordx4 v[16:19], v5, s[20:23], s47 offen
    buffer_load_dwordx2 v[32:33], v6, s[20:23], s48 offen
    s_add_u32 s47, s47, 0x200000
    s_add_u32 s48, s48, 0x8000
    buffer_load_dwordx4 v[20:23], v5, s[20:23], s47 offen
    buffer_load_dwordx2 v[34:35], v6, s[20:23], s48 offen
    s_add_u32 s47, s47, 0x200000
    s_add_u32 s48, s48, 0x8000
    buffer_load_dwordx4 v[24:27], v5, s[20:23], s47 offen
    buffer_load_dwordx2 v[36:37], v6, s[20:23], s48 offen
    s_add_u32 s47, s47, 0x200000
    s_add_u32 s48, s48, 0x8000
    buffer_load_dwordx4 v[28:31], v5, s[20:23], s47 offen
    buffer_load_dwordx2 v[38:39], v6, s[20:23], s48 offen
    s_add_u32 s47, s47, 0x200000
    s_add_u32 s48, s48, 0x8000
    s_waitcnt lgkmcnt(0)
    s_min_i32 s3, s44, 0x1000
    s_cmp_le_i32 s44, 0
    s_cselect_b32 s3, 0x1000, s3
    s_add_u32 s3, s3, 1023
    s_lshr_b32 s49, s3, 10
    s_waitcnt vmcnt(0)
    s_cmp_gt_u32 s49, 1
    s_cbranch_scc1 L_cv1
    v_mov_b32 v20, 0
    v_mov_b32 v21, 0
    v_mov_b32 v22, 0
    v_mov_b32 v23, 0
    v_mov_b32 v34, 0xff800000
    v_mov_b32 v35, 0
L_cv1:
    s_cmp_gt_u32 s49, 2
    s_cbranch_scc1 L_cv2
    v_mov_b32 v24, 0
    v_mov_b32 v25, 0
    v_mov_b32 v26, 0
    v_mov_b32 v27, 0
    v_mov_b32 v36, 0xff800000
    v_mov_b32 v37, 0
L_cv2:
    s_cmp_gt_u32 s49, 3
    s_cbranch_scc1 L_cv3
    v_mov_b32 v28, 0
    v_mov_b32 v29, 0
    v_mov_b32 v30, 0
    v_mov_b32 v31, 0
    v_mov_b32 v38, 0xff800000
    v_mov_b32 v39, 0
L_cv3:
    v_max_f32 v8, v32, v34
    v_max_f32 v8, v8, v36
    v_max_f32 v8, v8, v38
    v_sub_f32 v32, v32, v8
    v_sub_f32 v34, v34, v8
    v_sub_f32 v36, v36, v8
    v_sub_f32 v38, v38, v8
    v_exp_f32 v32, v32
    v_exp_f32 v34, v34
    v_exp_f32 v36, v36
    v_exp_f32 v38, v38
    v_mul_f32 v9, v32, v33
    v_fma_f32 v9, v34, v35, v9
    v_fma_f32 v9, v36, v37, v9
    v_fma_f32 v9, v38, v39, v9
    v_mul_f32 v10, v32, v16
    v_mul_f32 v11, v32, v17
    v_mul_f32 v12, v32, v18
    v_mul_f32 v13, v32, v19
    v_fma_f32 v10, v34, v20, v10
    v_fma_f32 v11, v34, v21, v11
    v_fma_f32 v12, v34, v22, v12
    v_fma_f32 v13, v34, v23, v13
    v_fma_f32 v10, v36, v24, v10
    v_fma_f32 v11, v36, v25, v11
    v_fma_f32 v12, v36, v26, v12
    v_fma_f32 v13, v36, v27, v13
    v_fma_f32 v10, v38, v28, v10
    v_fma_f32 v11, v38, v29, v11
    v_fma_f32 v12, v38, v30, v12
    v_fma_f32 v13, v38, v31, v13
    v_rcp_f32 v9, v9
    s_nop 0
    v_mul_f32 v10, v10, v9
    v_mul_f32 v11, v11, v9
    v_mul_f32 v12, v12, v9
    v_mul_f32 v13, v13, v9
    v_cvt_pk_bf16_f32 v14, v10, v11
    v_cvt_pk_bf16_f32 v15, v12, v13
    s_lshl_b32 s3, s2, 11
    buffer_store_dwordx2 v[14:15], v7, s[24:27], s3 offen
L_comb_done:
    s_endpgm
.section .rodata,"a"
.p2align 6
.amdhsa_kernel standalone__paged_block_table_kv_pagedattention__sampling_kernel
  .amdhsa_next_free_vgpr 176
  .amdhsa_next_free_sgpr 64
  .amdhsa_accum_offset 176
  .amdhsa_group_segment_fixed_size 0
  .amdhsa_kernarg_size 64
  .amdhsa_user_sgpr_count 2
  .amdhsa_user_sgpr_kernarg_segment_ptr 1
  .amdhsa_system_sgpr_workgroup_id_x 1
.end_amdhsa_kernel
.p2align 6
.amdhsa_kernel pa_combine_kernel
  .amdhsa_next_free_vgpr 48
  .amdhsa_next_free_sgpr 64
  .amdhsa_accum_offset 48
  .amdhsa_group_segment_fixed_size 0
  .amdhsa_kernarg_size 64
  .amdhsa_user_sgpr_count 2
  .amdhsa_user_sgpr_kernarg_segment_ptr 1
  .amdhsa_system_sgpr_workgroup_id_x 1
.end_amdhsa_kernel
```
